```python
import torch

def _softmax(x, axis=-1):
    return torch.softmax(x, dim=axis)
def _gelu(x):
    return torch.nn.functional.gelu(x, approximate="tanh")
def _silu(x):
    return torch.nn.functional.silu(x)
def _sigmoid(x):
    return torch.sigmoid(x)
def _layernorm(x, axis=-1, eps=1e-5):
    m = x.mean(dim=axis, keepdim=True)
    v = x.var(dim=axis, keepdim=True, unbiased=False)
    return (x - m) / torch.sqrt(v + eps)
def _scatter_add(tgt, idx, src, axis=0):
    return tgt.clone().index_add_(axis, idx, src)
def _segment_sum(src, seg, n):
    out = torch.zeros((n,) + src.shape[1:], dtype=src.dtype)
    return out.index_add_(0, seg, src)
def _pad(x, pw):
    flat = tuple(v for pair in reversed(pw) for v in pair)
    return torch.nn.functional.pad(x, flat)

kernel_name = 'standalone__mha_softmax__sampling'

def setup_inputs():

    _w = (lambda a: (lambda t: t.to(torch.bfloat16) if t.is_floating_point() else t)(torch.as_tensor(a)))
    B, H, Sq, Sk, D = 8, 32, 4, 4096, 192
    return {
        "q": _w((lambda *s: torch.randn(*s, dtype=torch.bfloat16) * 0.8)(B, H, Sq, D)),
        "k": _w((lambda *s: torch.randn(*s, dtype=torch.bfloat16) * 0.8)(B, H, Sk, D)),
        "v": _w((lambda *s: torch.randn(*s, dtype=torch.bfloat16) * 0.05)(B, H, Sk, D)),
    }

def reference(q, k, v):
    scale = q.shape[-1] ** -0.5
    scores = torch.einsum("bhqd,bhkd->bhqk", q, k) * scale
    p = _softmax(scores, axis=-1)
    return torch.einsum("bhqk,bhkd->bhqd", p, v)
```

```asm
; @launch grid=(256,1,1) block=(256,1,1) lds=16896
.amdgcn_target "amdgcn-amd-amdhsa--gfx950"
.text
.globl standalone__mha_softmax__sampling_kernel
.p2align 8
.type standalone__mha_softmax__sampling_kernel,@function
standalone__mha_softmax__sampling_kernel:
    s_load_dwordx8 s[4:11], s[0:1], 0
    s_cmp_ge_u32 s2, 256
    s_cbranch_scc1 L_done
    s_load_dwordx2 s[56:57], s[0:1], 32
    v_lshrrev_b32 v8, 6, v0
    v_and_b32 v18, 63, v0
    v_readfirstlane_b32 s3, v8
    v_and_b32 v9, 15, v0
    v_bfe_u32 v10, v0, 4, 2
    v_lshrrev_b32 v8, 1, v9
    v_mul_u32_u24 v1, 384, v8
    v_and_b32 v8, 1, v9
    v_lshl_add_u32 v8, v10, 1, v8
    v_lshl_add_u32 v1, v8, 4, v1
    s_mov_b32 s23, s2
    s_and_b32 s27, s2, 7
    s_mul_i32 s27, s27, 11
    s_lshr_b32 s28, s2, 3
    s_mul_i32 s28, s28, 1
    s_add_u32 s27, s27, s28
    s_and_b32 s27, s27, 31
    s_mul_i32 s27, s27, 49152
    s_mul_i32 s28, s3, 12288
    s_add_u32 s48, s27, s28
    s_add_u32 s49, s48, 6144
    s_mul_i32 s27, s23, 1572864
    s_mov_b32 s14, 1572864
    s_mov_b32 s15, 0x20000
    s_mov_b32 s18, 1572864
    s_mov_b32 s19, 0x20000
    v_mul_u32_u24 v11, 768, v10
    v_lshl_add_u32 v2, v9, 4, v11
    v_and_b32 v8, 7, v9
    v_lshl_add_u32 v3, v8, 4, v11
    v_lshrrev_b32 v8, 3, v9
    v_mul_u32_u24 v8, 384, v8
    v_add_u32 v3, v3, v8
    s_waitcnt lgkmcnt(0)
    s_add_u32 s12, s6, s27
    s_addc_u32 s13, s7, 0
    s_add_u32 s16, s8, s27
    s_addc_u32 s17, s9, 0
    buffer_load_dwordx4 a[0:3], v1, s[12:15], s48 offen offset:0 nt
    buffer_load_dwordx4 a[4:7], v1, s[12:15], s48 offen offset:128 nt
    buffer_load_dwordx4 a[8:11], v1, s[12:15], s48 offen offset:256 nt
    v_bfe_u32 v8, v9, 2, 1
    v_and_b32 v11, 3, v9
    v_mul_u32_u24 v32, 3, v8
    v_xor_b32 v11, v11, v32
    v_mul_u32_u24 v11, 384, v11
    v_lshl_add_u32 v32, v10, 1, v8
    v_lshl_add_u32 v11, v32, 4, v11
    s_mul_i32 s28, s23, 1536
    s_add_u32 s4, s4, s28
    s_addc_u32 s5, s5, 0
    global_load_dwordx4 v[20:23], v11, s[4:5] offset:0
    global_load_dwordx4 v[24:27], v11, s[4:5] offset:128
    global_load_dwordx4 v[28:31], v11, s[4:5] offset:256
    buffer_load_dwordx4 a[12:15], v1, s[12:15], s48 offen offset:3072 nt
    buffer_load_dwordx4 a[16:19], v1, s[12:15], s48 offen offset:3200 nt
    buffer_load_dwordx4 a[20:23], v1, s[12:15], s48 offen offset:3328 nt
    buffer_load_dwordx4 a[24:27], v1, s[12:15], s49 offen offset:0 nt
    buffer_load_dwordx4 a[28:31], v1, s[12:15], s49 offen offset:128 nt
    buffer_load_dwordx4 a[32:35], v1, s[12:15], s49 offen offset:256 nt
    buffer_load_dwordx4 a[36:39], v1, s[12:15], s49 offen offset:3072 nt
    buffer_load_dwordx4 a[40:43], v1, s[12:15], s49 offen offset:3200 nt
    buffer_load_dwordx4 a[44:47], v1, s[12:15], s49 offen offset:3328 nt
    buffer_load_dwordx4 v[56:59], v2, s[16:19], s48 offen offset:0 nt
    buffer_load_dwordx4 v[60:63], v2, s[16:19], s48 offen offset:384 nt
    buffer_load_dwordx4 v[64:67], v2, s[16:19], s48 offen offset:3072 nt
    buffer_load_dwordx4 v[68:71], v2, s[16:19], s48 offen offset:3456 nt
    buffer_load_dwordx4 v[72:75], v2, s[16:19], s49 offen offset:0 nt
    buffer_load_dwordx4 v[76:79], v2, s[16:19], s49 offen offset:384 nt
    buffer_load_dwordx4 v[80:83], v2, s[16:19], s49 offen offset:3072 nt
    buffer_load_dwordx4 v[84:87], v2, s[16:19], s49 offen offset:3456 nt
    buffer_load_dwordx4 v[88:91], v3, s[16:19], s48 offen offset:256 nt
    buffer_load_dwordx4 v[92:95], v3, s[16:19], s48 offen offset:3328 nt
    buffer_load_dwordx4 v[96:99], v3, s[16:19], s49 offen offset:256 nt
    buffer_load_dwordx4 v[100:103], v3, s[16:19], s49 offen offset:3328 nt
    s_getpc_b64 s[58:59]
L_pc:
    s_cmp_eq_u32 s3, 3
    s_cbranch_scc0 L_nowarm
    v_lshlrev_b32 v32, 7, v18
    s_mov_b32 s27, L_codeend - L_pc - 4
    v_min_u32 v33, s27, v32
    global_load_dword v227, v33, s[58:59]
    v_add_u32 v32, 8192, v32
    v_min_u32 v33, s27, v32
    global_load_dword v227, v33, s[58:59]
L_nowarm:
    s_add_u32 s10, s10, s28
    s_addc_u32 s11, s11, 0
    s_mov_b32 s32, s12
    s_mov_b32 s36, s16
    s_mov_b32 s33, s13
    s_mov_b32 s37, s17
    s_mov_b32 s34, s14
    s_mov_b32 s38, s18
    s_mov_b32 s35, s15
    s_mov_b32 s39, s19
    s_getreg_b32 s27, hwreg(HW_REG_XCC_ID)
    s_and_b32 s27, s27, 7
    s_lshl_b32 s27, s27, 5
    s_lshr_b32 s28, s2, 3
    s_and_b32 s28, s28, 31
    s_add_u32 s28, s28, s27
    v_mov_b32 v226, s28
    v_and_b32 v225, 7, v18
    v_lshlrev_b32 v225, 2, v225
    v_add_u32 v225, s27, v225
    v_mov_b32 v224, 0
    s_lshr_b32 s63, s27, 3
    s_lshr_b32 s63, 0x24340314, s63
    s_and_b32 s63, s63, 15
    s_add_u32 s63, s63, 53
    s_mov_b32 s24, 0x3dd53b95
    s_mov_b32 s25, 0x05040100
    s_mov_b32 s26, 0x07060302
    s_mov_b32 s22, 32
    v_bfe_u32 v8, v18, 3, 1
    v_mul_u32_u24 v8, 2, v8
    s_mov_b32 s27, 0x01010101
    v_mul_lo_u32 v8, v8, s27
    v_add_u32 v4, 0x05040100, v8
    v_mov_b32 v5, 0xff7fffff
    v_mov_b32 v11, 0x7f800000
    v_and_b32 v8, 4, v18
    v_cmp_ne_u32 vcc, 0, v8
    v_mov_b32 v7, 0
    s_nop 0
    v_cndmask_b32 v5, v5, v11, vcc
    v_mul_f32 v6, s24, v5
    v_and_b32 v8, 3, v18
    s_mul_i32 s27, s3, 4224
    v_mul_u32_u24 v216, 1040, v8
    v_lshl_add_u32 v216, v10, 7, v216
    v_add_u32 v216, s27, v216
    v_lshlrev_b32 v217, 3, v8
    v_add_u32 v217, s27, v217
    s_lshl_b32 s30, s3, 1
    s_cmp_eq_u32 s3, 2
    s_cselect_b32 s27, 4, 5
    s_cselect_b32 s28, 1, 3
    s_cselect_b32 s29, 4, 0
    s_cselect_b32 s30, 0, s30
    v_lshrrev_b32 v8, s27, v18
    v_add_u32 v8, s30, v8
    v_lshrrev_b32 v9, 3, v18
    v_and_b32 v9, s28, v9
    v_add_u32 v9, s29, v9
    v_and_b32 v11, 7, v18
    v_mul_u32_u24 v218, 1040, v8
    v_lshl_add_u32 v218, v9, 7, v218
    v_lshl_add_u32 v218, v11, 4, v218
    v_lshlrev_b32 v219, 3, v8
    v_mul_u32_u24 v220, 384, v8
    v_lshl_add_u32 v220, v9, 6, v220
    v_lshl_add_u32 v220, v11, 1, v220
    v_mov_b32 v152, 0
    v_mov_b32 v153, 0
    v_mov_b32 v154, 0
    v_mov_b32 v155, 0
    v_mov_b32 v156, 0
    v_mov_b32 v157, 0
    v_mov_b32 v158, 0
    v_mov_b32 v159, 0
    v_mov_b32 v160, 0
    v_mov_b32 v161, 0
    v_mov_b32 v162, 0
    v_mov_b32 v163, 0
    v_mov_b32 v164, 0
    v_mov_b32 v165, 0
    v_mov_b32 v166, 0
    v_mov_b32 v167, 0
    v_mov_b32 v168, 0
    v_mov_b32 v169, 0
    v_mov_b32 v170, 0
    v_mov_b32 v171, 0
    v_mov_b32 v172, 0
    v_mov_b32 v173, 0
    v_mov_b32 v174, 0
    v_mov_b32 v175, 0
    v_mov_b32 v176, 0
    v_mov_b32 v177, 0
    v_mov_b32 v178, 0
    v_mov_b32 v179, 0
    v_mov_b32 v180, 0
    v_mov_b32 v181, 0
    v_mov_b32 v182, 0
    v_mov_b32 v183, 0
    v_mov_b32 v184, 0
    v_mov_b32 v185, 0
    v_mov_b32 v186, 0
    v_mov_b32 v187, 0
    v_mov_b32 v188, 0
    v_mov_b32 v189, 0
    v_mov_b32 v190, 0
    v_mov_b32 v191, 0
    v_mov_b32 v192, 0
    v_mov_b32 v193, 0
    v_mov_b32 v194, 0
    v_mov_b32 v195, 0
    v_mov_b32 v196, 0
    v_mov_b32 v197, 0
    v_mov_b32 v198, 0
    v_mov_b32 v199, 0
    v_mov_b32 v200, 0
    v_mov_b32 v201, 0
    v_mov_b32 v202, 0
    v_mov_b32 v203, 0
    v_mov_b32 v204, 0
    v_mov_b32 v205, 0
    v_mov_b32 v206, 0
    v_mov_b32 v207, 0
    v_mov_b32 v208, 0
    v_mov_b32 v209, 0
    v_mov_b32 v210, 0
    v_mov_b32 v211, 0
    v_mov_b32 v212, 0
    v_mov_b32 v213, 0
    v_mov_b32 v214, 0
    v_mov_b32 v215, 0
    .p2align 6
    s_branch L_loop0
L_disp:
    s_cmp_le_u32 s22, 3
    s_cbranch_scc1 L_totail
    v_sad_u8 v8, v224, 0, 0
    s_sub_u32 s28, 32, s22
    s_nop 0
    v_add_u32_dpp v8, v8, v8 row_shr:1 row_mask:0xf bank_mask:0xf bound_ctrl:0
    s_lshl_b32 s29, s28, 5
    s_sub_u32 s29, s29, s63
    v_add_u32_dpp v8, v8, v8 row_shr:2 row_mask:0xf bank_mask:0xf bound_ctrl:0
    v_mov_b32 v9, s28
    s_nop 0
    v_add_u32_dpp v8, v8, v8 row_shr:4 row_mask:0xf bank_mask:0xf bound_ctrl:0
    s_cmp_eq_u32 s3, 0
    s_cbranch_scc0 L_nopub
    s_mov_b64 exec, 1
    global_store_byte v226, v9, s[56:57]
    s_mov_b64 exec, -1
L_nopub:
    v_readlane_b32 s30, v8, 7
    s_mov_b64 exec, 0xff
    global_load_dword v224, v225, s[56:57] sc1
    s_mov_b64 exec, -1
    s_sub_i32 s29, s29, s30
    s_cmp_eq_u32 s28, 1
    s_cselect_b32 s29, 0, s29
    s_cmp_gt_i32 s29, 4
    s_cbranch_scc1 L_loop3
    s_cmp_lt_i32 s29, -4
    s_cbranch_scc1 L_loop4
    .p2align 6
L_loop0:
    s_add_u32 s52, s48, 49152
    s_cmp_ge_u32 s52, 1572864
    s_cselect_b32 s27, 1572864, 0
    s_sub_u32 s52, s52, s27
    s_add_u32 s53, s52, 6144
    s_waitcnt vmcnt(21)
    v_mfma_f32_16x16x32_bf16 v[32:35], a[0:3], v[20:23], 0
    v_mfma_f32_16x16x32_bf16 v[32:35], a[4:7], v[24:27], v[32:35]
    v_mfma_f32_16x16x32_bf16 v[32:35], a[8:11], v[28:31], v[32:35]
    s_waitcnt vmcnt(5)
    buffer_load_dwordx4 a[0:3], v1, s[32:35], s52 offen offset:0 nt
    s_waitcnt vmcnt(5)
    buffer_load_dwordx4 a[4:7], v1, s[32:35], s52 offen offset:128 nt
    s_waitcnt vmcnt(4)
    buffer_load_dwordx4 a[8:11], v1, s[32:35], s52 offen offset:256 nt
    s_waitcnt vmcnt(21)
    v_mfma_f32_16x16x32_bf16 v[36:39], a[12:15], v[20:23], 0
    v_mfma_f32_16x16x32_bf16 v[36:39], a[16:19], v[24:27], v[36:39]
    v_mfma_f32_16x16x32_bf16 v[36:39], a[20:23], v[28:31], v[36:39]
    s_waitcnt vmcnt(5)
    buffer_load_dwordx4 a[12:15], v1, s[32:35], s52 offen offset:3072 nt
    s_waitcnt vmcnt(5)
    buffer_load_dwordx4 a[16:19], v1, s[32:35], s52 offen offset:3200 nt
    s_waitcnt vmcnt(4)
    buffer_load_dwordx4 a[20:23], v1, s[32:35], s52 offen offset:3328 nt
    s_waitcnt vmcnt(21)
    v_mfma_f32_16x16x32_bf16 v[40:43], a[24:27], v[20:23], 0
    v_mfma_f32_16x16x32_bf16 v[40:43], a[28:31], v[24:27], v[40:43]
    v_mfma_f32_16x16x32_bf16 v[40:43], a[32:35], v[28:31], v[40:43]
    s_waitcnt vmcnt(5)
    buffer_load_dwordx4 a[24:27], v1, s[32:35], s53 offen offset:0 nt
    s_waitcnt vmcnt(5)
    buffer_load_dwordx4 a[28:31], v1, s[32:35], s53 offen offset:128 nt
    s_waitcnt vmcnt(4)
    buffer_load_dwordx4 a[32:35], v1, s[32:35], s53 offen offset:256 nt
    s_waitcnt vmcnt(21)
    v_mfma_f32_16x16x32_bf16 v[44:47], a[36:39], v[20:23], 0
    v_mfma_f32_16x16x32_bf16 v[44:47], a[40:43], v[24:27], v[44:47]
    v_mfma_f32_16x16x32_bf16 v[44:47], a[44:47], v[28:31], v[44:47]
    s_waitcnt vmcnt(5)
    buffer_load_dwordx4 a[36:39], v1, s[32:35], s53 offen offset:3072 nt
    s_waitcnt vmcnt(5)
    buffer_load_dwordx4 a[40:43], v1, s[32:35], s53 offen offset:3200 nt
    s_waitcnt vmcnt(4)
    buffer_load_dwordx4 a[44:47], v1, s[32:35], s53 offen offset:3328 nt
    s_nop 4
    v_add_f32_dpp v32, v33, v32 row_half_mirror row_mask:0xf bank_mask:0xf
    v_add_f32_dpp v34, v35, v34 row_half_mirror row_mask:0xf bank_mask:0xf
    v_add_f32_dpp v36, v37, v36 row_half_mirror row_mask:0xf bank_mask:0xf
    v_add_f32_dpp v38, v39, v38 row_half_mirror row_mask:0xf bank_mask:0xf
    v_add_f32_dpp v40, v41, v40 row_half_mirror row_mask:0xf bank_mask:0xf
    v_add_f32_dpp v42, v43, v42 row_half_mirror row_mask:0xf bank_mask:0xf
    v_add_f32_dpp v44, v45, v44 row_half_mirror row_mask:0xf bank_mask:0xf
    v_add_f32_dpp v46, v47, v46 row_half_mirror row_mask:0xf bank_mask:0xf
    v_max3_f32 v8, v32, v34, v36
    v_max3_f32 v9, v38, v40, v42
    v_max3_f32 v8, v8, v44, v46
    v_max_f32 v8, v8, v9
    v_cmp_gt_f32 vcc, v8, v5
    s_cbranch_vccnz L_rescale0
L_back0:
    v_fma_f32 v48, v32, s24, -v6
    v_fma_f32 v49, v34, s24, -v6
    v_fma_f32 v50, v36, s24, -v6
    v_fma_f32 v51, v38, s24, -v6
    v_fma_f32 v52, v40, s24, -v6
    v_fma_f32 v53, v42, s24, -v6
    v_fma_f32 v54, v44, s24, -v6
    v_fma_f32 v55, v46, s24, -v6
    v_exp_f32 v48, v48
    v_exp_f32 v49, v49
    v_exp_f32 v50, v50
    v_exp_f32 v51, v51
    v_exp_f32 v52, v52
    v_exp_f32 v53, v53
    v_exp_f32 v54, v54
    v_exp_f32 v55, v55
    s_nop 0
    v_cvt_pk_bf16_f32 v12, v48, v49
    v_cvt_pk_bf16_f32 v13, v50, v51
    v_cvt_pk_bf16_f32 v14, v52, v53
    v_cvt_pk_bf16_f32 v15, v54, v55
    v_add_f32 v8, v48, v49
    v_add_f32 v9, v50, v51
    v_add_f32 v10, v52, v53
    v_add_f32 v11, v54, v55
    v_perm_b32 v16, v13, v12, v4
    v_perm_b32 v17, v15, v14, v4
    v_add_f32 v8, v8, v9
    v_add_f32 v10, v10, v11
    v_add_f32 v7, v7, v8
    v_add_f32 v7, v7, v10
    s_waitcnt vmcnt(22)
    v_perm_b32 v104, v60, v56, s25
    v_perm_b32 v108, v60, v56, s26
    v_perm_b32 v112, v61, v57, s25
    v_perm_b32 v116, v61, v57, s26
    v_perm_b32 v120, v62, v58, s25
    v_perm_b32 v124, v62, v58, s26
    v_perm_b32 v128, v63, v59, s25
    v_perm_b32 v132, v63, v59, s26
    s_waitcnt vmcnt(5)
    buffer_load_dwordx4 v[56:59], v2, s[36:39], s52 offen offset:0 nt
    s_waitcnt vmcnt(5)
    buffer_load_dwordx4 v[60:63], v2, s[36:39], s52 offen offset:384 nt
    s_waitcnt vmcnt(22)
    v_perm_b32 v105, v68, v64, s25
    v_perm_b32 v109, v68, v64, s26
    v_perm_b32 v113, v69, v65, s25
    v_perm_b32 v117, v69, v65, s26
    v_perm_b32 v121, v70, v66, s25
    v_perm_b32 v125, v70, v66, s26
    v_perm_b32 v129, v71, v67, s25
    v_perm_b32 v133, v71, v67, s26
    s_waitcnt vmcnt(4)
    buffer_load_dwordx4 v[64:67], v2, s[36:39], s52 offen offset:3072 nt
    s_waitcnt vmcnt(5)
    buffer_load_dwordx4 v[68:71], v2, s[36:39], s52 offen offset:3456 nt
    s_waitcnt vmcnt(22)
    v_perm_b32 v106, v76, v72, s25
    v_perm_b32 v110, v76, v72, s26
    v_perm_b32 v114, v77, v73, s25
    v_perm_b32 v118, v77, v73, s26
    v_perm_b32 v122, v78, v74, s25
    v_perm_b32 v126, v78, v74, s26
    v_perm_b32 v130, v79, v75, s25
    v_perm_b32 v134, v79, v75, s26
    s_waitcnt vmcnt(5)
    buffer_load_dwordx4 v[72:75], v2, s[36:39], s53 offen offset:0 nt
    s_waitcnt vmcnt(4)
    buffer_load_dwordx4 v[76:79], v2, s[36:39], s53 offen offset:384 nt
    s_waitcnt vmcnt(22)
    v_perm_b32 v107, v84, v80, s25
    v_perm_b32 v111, v84, v80, s26
    v_perm_b32 v115, v85, v81, s25
    v_perm_b32 v119, v85, v81, s26
    v_perm_b32 v123, v86, v82, s25
    v_perm_b32 v127, v86, v82, s26
    v_perm_b32 v131, v87, v83, s25
    v_perm_b32 v135, v87, v83, s26
    s_waitcnt vmcnt(5)
    buffer_load_dwordx4 v[80:83], v2, s[36:39], s53 offen offset:3072 nt
    s_waitcnt vmcnt(5)
    buffer_load_dwordx4 v[84:87], v2, s[36:39], s53 offen offset:3456 nt
    v_mfma_f32_16x16x32_bf16 v[152:155], v[104:107], v[12:15], v[152:155]
    v_mfma_f32_16x16x32_bf16 v[156:159], v[108:111], v[12:15], v[156:159]
    v_mfma_f32_16x16x32_bf16 v[160:163], v[112:115], v[12:15], v[160:163]
    v_mfma_f32_16x16x32_bf16 v[164:167], v[116:119], v[12:15], v[164:167]
    v_mfma_f32_16x16x32_bf16 v[168:171], v[120:123], v[12:15], v[168:171]
    v_mfma_f32_16x16x32_bf16 v[172:175], v[124:127], v[12:15], v[172:175]
    v_mfma_f32_16x16x32_bf16 v[176:179], v[128:131], v[12:15], v[176:179]
    v_mfma_f32_16x16x32_bf16 v[180:183], v[132:135], v[12:15], v[180:183]
    s_waitcnt vmcnt(22)
    v_perm_b32 v136, v92, v88, s25
    v_perm_b32 v138, v92, v88, s26
    v_perm_b32 v140, v93, v89, s25
    v_perm_b32 v142, v93, v89, s26
    v_perm_b32 v144, v94, v90, s25
    v_perm_b32 v146, v94, v90, s26
    v_perm_b32 v148, v95, v91, s25
    v_perm_b32 v150, v95, v91, s26
    s_waitcnt vmcnt(4)
    buffer_load_dwordx4 v[88:91], v3, s[36:39], s52 offen offset:256 nt
    s_waitcnt vmcnt(5)
    buffer_load_dwordx4 v[92:95], v3, s[36:39], s52 offen offset:3328 nt
    s_waitcnt vmcnt(22)
    v_perm_b32 v137, v100, v96, s25
    v_perm_b32 v139, v100, v96, s26
    v_perm_b32 v141, v101, v97, s25
    v_perm_b32 v143, v101, v97, s26
    v_perm_b32 v145, v102, v98, s25
    v_perm_b32 v147, v102, v98, s26
    v_perm_b32 v149, v103, v99, s25
    v_perm_b32 v151, v103, v99, s26
    s_waitcnt vmcnt(5)
    buffer_load_dwordx4 v[96:99], v3, s[36:39], s53 offen offset:256 nt
    s_waitcnt vmcnt(4)
    buffer_load_dwordx4 v[100:103], v3, s[36:39], s53 offen offset:3328 nt
    v_mfma_f32_16x16x16_bf16 v[184:187], v[136:137], v[16:17], v[184:187]
    v_mfma_f32_16x16x16_bf16 v[188:191], v[138:139], v[16:17], v[188:191]
    v_mfma_f32_16x16x16_bf16 v[192:195], v[140:141], v[16:17], v[192:195]
    v_mfma_f32_16x16x16_bf16 v[196:199], v[142:143], v[16:17], v[196:199]
    v_mfma_f32_16x16x16_bf16 v[200:203], v[144:145], v[16:17], v[200:203]
    v_mfma_f32_16x16x16_bf16 v[204:207], v[146:147], v[16:17], v[204:207]
    v_mfma_f32_16x16x16_bf16 v[208:211], v[148:149], v[16:17], v[208:211]
    v_mfma_f32_16x16x16_bf16 v[212:215], v[150:151], v[16:17], v[212:215]
    s_mov_b32 s48, s52
    s_mov_b32 s49, s53
    s_sub_u32 s22, s22, 1
    s_branch L_disp
    .p2align 6
L_loop3:
    s_add_u32 s52, s48, 49152
    s_cmp_ge_u32 s52, 1572864
    s_cselect_b32 s27, 1572864, 0
    s_sub_u32 s52, s52, s27
    s_add_u32 s53, s52, 6144
    s_waitcnt vmcnt(21)
    v_mfma_f32_16x16x32_bf16 v[32:35], a[0:3], v[20:23], 0
    v_mfma_f32_16x16x32_bf16 v[32:35], a[4:7], v[24:27], v[32:35]
    v_mfma_f32_16x16x32_bf16 v[32:35], a[8:11], v[28:31], v[32:35]
    s_waitcnt vmcnt(4)
    buffer_load_dwordx4 a[0:3], v1, s[32:35], s52 offen offset:0 nt
    s_waitcnt vmcnt(4)
    buffer_load_dwordx4 a[4:7], v1, s[32:35], s52 offen offset:128 nt
    s_waitcnt vmcnt(4)
    buffer_load_dwordx4 a[8:11], v1, s[32:35], s52 offen offset:256 nt
    s_waitcnt vmcnt(21)
    v_mfma_f32_16x16x32_bf16 v[36:39], a[12:15], v[20:23], 0
    v_mfma_f32_16x16x32_bf16 v[36:39], a[16:19], v[24:27], v[36:39]
    v_mfma_f32_16x16x32_bf16 v[36:39], a[20:23], v[28:31], v[36:39]
    s_waitcnt vmcnt(4)
    buffer_load_dwordx4 a[12:15], v1, s[32:35], s52 offen offset:3072 nt
    s_waitcnt vmcnt(4)
    buffer_load_dwordx4 a[16:19], v1, s[32:35], s52 offen offset:3200 nt
    s_waitcnt vmcnt(4)
    buffer_load_dwordx4 a[20:23], v1, s[32:35], s52 offen offset:3328 nt
    s_waitcnt vmcnt(21)
    v_mfma_f32_16x16x32_bf16 v[40:43], a[24:27], v[20:23], 0
    v_mfma_f32_16x16x32_bf16 v[40:43], a[28:31], v[24:27], v[40:43]
    v_mfma_f32_16x16x32_bf16 v[40:43], a[32:35], v[28:31], v[40:43]
    s_waitcnt vmcnt(4)
    buffer_load_dwordx4 a[24:27], v1, s[32:35], s53 offen offset:0 nt
    s_waitcnt vmcnt(4)
    buffer_load_dwordx4 a[28:31], v1, s[32:35], s53 offen offset:128 nt
    s_waitcnt vmcnt(4)
    buffer_load_dwordx4 a[32:35], v1, s[32:35], s53 offen offset:256 nt
    s_waitcnt vmcnt(21)
    v_mfma_f32_16x16x32_bf16 v[44:47], a[36:39], v[20:23], 0
    v_mfma_f32_16x16x32_bf16 v[44:47], a[40:43], v[24:27], v[44:47]
    v_mfma_f32_16x16x32_bf16 v[44:47], a[44:47], v[28:31], v[44:47]
    s_waitcnt vmcnt(4)
    buffer_load_dwordx4 a[36:39], v1, s[32:35], s53 offen offset:3072 nt
    s_waitcnt vmcnt(4)
    buffer_load_dwordx4 a[40:43], v1, s[32:35], s53 offen offset:3200 nt
    s_waitcnt vmcnt(4)
    buffer_load_dwordx4 a[44:47], v1, s[32:35], s53 offen offset:3328 nt
    s_nop 4
    v_add_f32_dpp v32, v33, v32 row_half_mirror row_mask:0xf bank_mask:0xf
    v_add_f32_dpp v34, v35, v34 row_half_mirror row_mask:0xf bank_mask:0xf
    v_add_f32_dpp v36, v37, v36 row_half_mirror row_mask:0xf bank_mask:0xf
    v_add_f32_dpp v38, v39, v38 row_half_mirror row_mask:0xf bank_mask:0xf
    v_add_f32_dpp v40, v41, v40 row_half_mirror row_mask:0xf bank_mask:0xf
    v_add_f32_dpp v42, v43, v42 row_half_mirror row_mask:0xf bank_mask:0xf
    v_add_f32_dpp v44, v45, v44 row_half_mirror row_mask:0xf bank_mask:0xf
    v_add_f32_dpp v46, v47, v46 row_half_mirror row_mask:0xf bank_mask:0xf
    v_max3_f32 v8, v32, v34, v36
    v_max3_f32 v9, v38, v40, v42
    v_max3_f32 v8, v8, v44, v46
    v_max_f32 v8, v8, v9
    v_cmp_gt_f32 vcc, v8, v5
    s_cbranch_vccnz L_rescale3
L_back3:
    v_fma_f32 v48, v32, s24, -v6
    v_fma_f32 v49, v34, s24, -v6
    v_fma_f32 v50, v36, s24, -v6
    v_fma_f32 v51, v38, s24, -v6
    v_fma_f32 v52, v40, s24, -v6
    v_fma_f32 v53, v42, s24, -v6
    v_fma_f32 v54, v44, s24, -v6
    v_fma_f32 v55, v46, s24, -v6
    v_exp_f32 v48, v48
    v_exp_f32 v49, v49
    v_exp_f32 v50, v50
    v_exp_f32 v51, v51
    v_exp_f32 v52, v52
    v_exp_f32 v53, v53
    v_exp_f32 v54, v54
    v_exp_f32 v55, v55
    s_nop 0
    v_cvt_pk_bf16_f32 v12, v48, v49
    v_cvt_pk_bf16_f32 v13, v50, v51
    v_cvt_pk_bf16_f32 v14, v52, v53
    v_cvt_pk_bf16_f32 v15, v54, v55
    v_add_f32 v8, v48, v49
    v_add_f32 v9, v50, v51
    v_add_f32 v10, v52, v53
    v_add_f32 v11, v54, v55
    v_perm_b32 v16, v13, v12, v4
    v_perm_b32 v17, v15, v14, v4
    v_add_f32 v8, v8, v9
    v_add_f32 v10, v10, v11
    v_add_f32 v7, v7, v8
    v_add_f32 v7, v7, v10
    s_waitcnt vmcnt(22)
    v_perm_b32 v104, v60, v56, s25
    v_perm_b32 v108, v60, v56, s26
    v_perm_b32 v112, v61, v57, s25
    v_perm_b32 v116, v61, v57, s26
    v_perm_b32 v120, v62, v58, s25
    v_perm_b32 v124, v62, v58, s26
    v_perm_b32 v128, v63, v59, s25
    v_perm_b32 v132, v63, v59, s26
    s_waitcnt vmcnt(4)
    buffer_load_dwordx4 v[56:59], v2, s[36:39], s52 offen offset:0 nt
    s_waitcnt vmcnt(4)
    buffer_load_dwordx4 v[60:63], v2, s[36:39], s52 offen offset:384 nt
    s_waitcnt vmcnt(22)
    v_perm_b32 v105, v68, v64, s25
    v_perm_b32 v109, v68, v64, s26
    v_perm_b32 v113, v69, v65, s25
    v_perm_b32 v117, v69, v65, s26
    v_perm_b32 v121, v70, v66, s25
    v_perm_b32 v125, v70, v66, s26
    v_perm_b32 v129, v71, v67, s25
    v_perm_b32 v133, v71, v67, s26
    s_waitcnt vmcnt(4)
    buffer_load_dwordx4 v[64:67], v2, s[36:39], s52 offen offset:3072 nt
    s_waitcnt vmcnt(4)
    buffer_load_dwordx4 v[68:71], v2, s[36:39], s52 offen offset:3456 nt
    s_waitcnt vmcnt(22)
    v_perm_b32 v106, v76, v72, s25
    v_perm_b32 v110, v76, v72, s26
    v_perm_b32 v114, v77, v73, s25
    v_perm_b32 v118, v77, v73, s26
    v_perm_b32 v122, v78, v74, s25
    v_perm_b32 v126, v78, v74, s26
    v_perm_b32 v130, v79, v75, s25
    v_perm_b32 v134, v79, v75, s26
    s_waitcnt vmcnt(4)
    buffer_load_dwordx4 v[72:75], v2, s[36:39], s53 offen offset:0 nt
    s_waitcnt vmcnt(4)
    buffer_load_dwordx4 v[76:79], v2, s[36:39], s53 offen offset:384 nt
    s_waitcnt vmcnt(22)
    v_perm_b32 v107, v84, v80, s25
    v_perm_b32 v111, v84, v80, s26
    v_perm_b32 v115, v85, v81, s25
    v_perm_b32 v119, v85, v81, s26
    v_perm_b32 v123, v86, v82, s25
    v_perm_b32 v127, v86, v82, s26
    v_perm_b32 v131, v87, v83, s25
    v_perm_b32 v135, v87, v83, s26
    s_waitcnt vmcnt(4)
    buffer_load_dwordx4 v[80:83], v2, s[36:39], s53 offen offset:3072 nt
    s_waitcnt vmcnt(4)
    buffer_load_dwordx4 v[84:87], v2, s[36:39], s53 offen offset:3456 nt
    v_mfma_f32_16x16x32_bf16 v[152:155], v[104:107], v[12:15], v[152:155]
    v_mfma_f32_16x16x32_bf16 v[156:159], v[108:111], v[12:15], v[156:159]
    v_mfma_f32_16x16x32_bf16 v[160:163], v[112:115], v[12:15], v[160:163]
    v_mfma_f32_16x16x32_bf16 v[164:167], v[116:119], v[12:15], v[164:167]
    v_mfma_f32_16x16x32_bf16 v[168:171], v[120:123], v[12:15], v[168:171]
    v_mfma_f32_16x16x32_bf16 v[172:175], v[124:127], v[12:15], v[172:175]
    v_mfma_f32_16x16x32_bf16 v[176:179], v[128:131], v[12:15], v[176:179]
    v_mfma_f32_16x16x32_bf16 v[180:183], v[132:135], v[12:15], v[180:183]
    s_waitcnt vmcnt(22)
    v_perm_b32 v136, v92, v88, s25
    v_perm_b32 v138, v92, v88, s26
    v_perm_b32 v140, v93, v89, s25
    v_perm_b32 v142, v93, v89, s26
    v_perm_b32 v144, v94, v90, s25
    v_perm_b32 v146, v94, v90, s26
    v_perm_b32 v148, v95, v91, s25
    v_perm_b32 v150, v95, v91, s26
    s_waitcnt vmcnt(4)
    buffer_load_dwordx4 v[88:91], v3, s[36:39], s52 offen offset:256 nt
    s_waitcnt vmcnt(4)
    buffer_load_dwordx4 v[92:95], v3, s[36:39], s52 offen offset:3328 nt
    s_waitcnt vmcnt(22)
    v_perm_b32 v137, v100, v96, s25
    v_perm_b32 v139, v100, v96, s26
    v_perm_b32 v141, v101, v97, s25
    v_perm_b32 v143, v101, v97, s26
    v_perm_b32 v145, v102, v98, s25
    v_perm_b32 v147, v102, v98, s26
    v_perm_b32 v149, v103, v99, s25
    v_perm_b32 v151, v103, v99, s26
    s_waitcnt vmcnt(4)
    buffer_load_dwordx4 v[96:99], v3, s[36:39], s53 offen offset:256 nt
    s_waitcnt vmcnt(4)
    buffer_load_dwordx4 v[100:103], v3, s[36:39], s53 offen offset:3328 nt
    v_mfma_f32_16x16x16_bf16 v[184:187], v[136:137], v[16:17], v[184:187]
    v_mfma_f32_16x16x16_bf16 v[188:191], v[138:139], v[16:17], v[188:191]
    v_mfma_f32_16x16x16_bf16 v[192:195], v[140:141], v[16:17], v[192:195]
    v_mfma_f32_16x16x16_bf16 v[196:199], v[142:143], v[16:17], v[196:199]
    v_mfma_f32_16x16x16_bf16 v[200:203], v[144:145], v[16:17], v[200:203]
    v_mfma_f32_16x16x16_bf16 v[204:207], v[146:147], v[16:17], v[204:207]
    v_mfma_f32_16x16x16_bf16 v[208:211], v[148:149], v[16:17], v[208:211]
    v_mfma_f32_16x16x16_bf16 v[212:215], v[150:151], v[16:17], v[212:215]
    s_mov_b32 s48, s52
    s_mov_b32 s49, s53
    s_sub_u32 s22, s22, 1
    s_branch L_disp
    .p2align 6
L_loop4:
    s_add_u32 s52, s48, 49152
    s_cmp_ge_u32 s52, 1572864
    s_cselect_b32 s27, 1572864, 0
    s_sub_u32 s52, s52, s27
    s_add_u32 s53, s52, 6144
    s_waitcnt vmcnt(21)
    v_mfma_f32_16x16x32_bf16 v[32:35], a[0:3], v[20:23], 0
    v_mfma_f32_16x16x32_bf16 v[32:35], a[4:7], v[24:27], v[32:35]
    v_mfma_f32_16x16x32_bf16 v[32:35], a[8:11], v[28:31], v[32:35]
    s_waitcnt vmcnt(6)
    buffer_load_dwordx4 a[0:3], v1, s[32:35], s52 offen offset:0 nt
    s_waitcnt vmcnt(5)
    buffer_load_dwordx4 a[4:7], v1, s[32:35], s52 offen offset:128 nt
    s_waitcnt vmcnt(6)
    buffer_load_dwordx4 a[8:11], v1, s[32:35], s52 offen offset:256 nt
    s_waitcnt vmcnt(21)
    v_mfma_f32_16x16x32_bf16 v[36:39], a[12:15], v[20:23], 0
    v_mfma_f32_16x16x32_bf16 v[36:39], a[16:19], v[24:27], v[36:39]
    v_mfma_f32_16x16x32_bf16 v[36:39], a[20:23], v[28:31], v[36:39]
    s_waitcnt vmcnt(6)
    buffer_load_dwordx4 a[12:15], v1, s[32:35], s52 offen offset:3072 nt
    s_waitcnt vmcnt(5)
    buffer_load_dwordx4 a[16:19], v1, s[32:35], s52 offen offset:3200 nt
    s_waitcnt vmcnt(6)
    buffer_load_dwordx4 a[20:23], v1, s[32:35], s52 offen offset:3328 nt
    s_waitcnt vmcnt(21)
    v_mfma_f32_16x16x32_bf16 v[40:43], a[24:27], v[20:23], 0
    v_mfma_f32_16x16x32_bf16 v[40:43], a[28:31], v[24:27], v[40:43]
    v_mfma_f32_16x16x32_bf16 v[40:43], a[32:35], v[28:31], v[40:43]
    s_waitcnt vmcnt(6)
    buffer_load_dwordx4 a[24:27], v1, s[32:35], s53 offen offset:0 nt
    s_waitcnt vmcnt(5)
    buffer_load_dwordx4 a[28:31], v1, s[32:35], s53 offen offset:128 nt
    s_waitcnt vmcnt(6)
    buffer_load_dwordx4 a[32:35], v1, s[32:35], s53 offen offset:256 nt
    s_waitcnt vmcnt(21)
    v_mfma_f32_16x16x32_bf16 v[44:47], a[36:39], v[20:23], 0
    v_mfma_f32_16x16x32_bf16 v[44:47], a[40:43], v[24:27], v[44:47]
    v_mfma_f32_16x16x32_bf16 v[44:47], a[44:47], v[28:31], v[44:47]
    s_waitcnt vmcnt(6)
    buffer_load_dwordx4 a[36:39], v1, s[32:35], s53 offen offset:3072 nt
    s_waitcnt vmcnt(5)
    buffer_load_dwordx4 a[40:43], v1, s[32:35], s53 offen offset:3200 nt
    s_waitcnt vmcnt(6)
    buffer_load_dwordx4 a[44:47], v1, s[32:35], s53 offen offset:3328 nt
    s_nop 4
    v_add_f32_dpp v32, v33, v32 row_half_mirror row_mask:0xf bank_mask:0xf
    v_add_f32_dpp v34, v35, v34 row_half_mirror row_mask:0xf bank_mask:0xf
    v_add_f32_dpp v36, v37, v36 row_half_mirror row_mask:0xf bank_mask:0xf
    v_add_f32_dpp v38, v39, v38 row_half_mirror row_mask:0xf bank_mask:0xf
    v_add_f32_dpp v40, v41, v40 row_half_mirror row_mask:0xf bank_mask:0xf
    v_add_f32_dpp v42, v43, v42 row_half_mirror row_mask:0xf bank_mask:0xf
    v_add_f32_dpp v44, v45, v44 row_half_mirror row_mask:0xf bank_mask:0xf
    v_add_f32_dpp v46, v47, v46 row_half_mirror row_mask:0xf bank_mask:0xf
    v_max3_f32 v8, v32, v34, v36
    v_max3_f32 v9, v38, v40, v42
    v_max3_f32 v8, v8, v44, v46
    v_max_f32 v8, v8, v9
    v_cmp_gt_f32 vcc, v8, v5
    s_cbranch_vccnz L_rescale4
L_back4:
    v_fma_f32 v48, v32, s24, -v6
    v_fma_f32 v49, v34, s24, -v6
    v_fma_f32 v50, v36, s24, -v6
    v_fma_f32 v51, v38, s24, -v6
    v_fma_f32 v52, v40, s24, -v6
    v_fma_f32 v53, v42, s24, -v6
    v_fma_f32 v54, v44, s24, -v6
    v_fma_f32 v55, v46, s24, -v6
    v_exp_f32 v48, v48
    v_exp_f32 v49, v49
    v_exp_f32 v50, v50
    v_exp_f32 v51, v51
    v_exp_f32 v52, v52
    v_exp_f32 v53, v53
    v_exp_f32 v54, v54
    v_exp_f32 v55, v55
    s_nop 0
    v_cvt_pk_bf16_f32 v12, v48, v49
    v_cvt_pk_bf16_f32 v13, v50, v51
    v_cvt_pk_bf16_f32 v14, v52, v53
    v_cvt_pk_bf16_f32 v15, v54, v55
    v_add_f32 v8, v48, v49
    v_add_f32 v9, v50, v51
    v_add_f32 v10, v52, v53
    v_add_f32 v11, v54, v55
    v_perm_b32 v16, v13, v12, v4
    v_perm_b32 v17, v15, v14, v4
    v_add_f32 v8, v8, v9
    v_add_f32 v10, v10, v11
    v_add_f32 v7, v7, v8
    v_add_f32 v7, v7, v10
    s_waitcnt vmcnt(22)
    v_perm_b32 v104, v60, v56, s25
    v_perm_b32 v108, v60, v56, s26
    v_perm_b32 v112, v61, v57, s25
    v_perm_b32 v116, v61, v57, s26
    v_perm_b32 v120, v62, v58, s25
    v_perm_b32 v124, v62, v58, s26
    v_perm_b32 v128, v63, v59, s25
    v_perm_b32 v132, v63, v59, s26
    s_waitcnt vmcnt(6)
    buffer_load_dwordx4 v[56:59], v2, s[36:39], s52 offen offset:0 nt
    s_waitcnt vmcnt(5)
    buffer_load_dwordx4 v[60:63], v2, s[36:39], s52 offen offset:384 nt
    s_waitcnt vmcnt(22)
    v_perm_b32 v105, v68, v64, s25
    v_perm_b32 v109, v68, v64, s26
    v_perm_b32 v113, v69, v65, s25
    v_perm_b32 v117, v69, v65, s26
    v_perm_b32 v121, v70, v66, s25
    v_perm_b32 v125, v70, v66, s26
    v_perm_b32 v129, v71, v67, s25
    v_perm_b32 v133, v71, v67, s26
    s_waitcnt vmcnt(6)
    buffer_load_dwordx4 v[64:67], v2, s[36:39], s52 offen offset:3072 nt
    s_waitcnt vmcnt(6)
    buffer_load_dwordx4 v[68:71], v2, s[36:39], s52 offen offset:3456 nt
    s_waitcnt vmcnt(22)
    v_perm_b32 v106, v76, v72, s25
    v_perm_b32 v110, v76, v72, s26
    v_perm_b32 v114, v77, v73, s25
    v_perm_b32 v118, v77, v73, s26
    v_perm_b32 v122, v78, v74, s25
    v_perm_b32 v126, v78, v74, s26
    v_perm_b32 v130, v79, v75, s25
    v_perm_b32 v134, v79, v75, s26
    s_waitcnt vmcnt(5)
    buffer_load_dwordx4 v[72:75], v2, s[36:39], s53 offen offset:0 nt
    s_waitcnt vmcnt(6)
    buffer_load_dwordx4 v[76:79], v2, s[36:39], s53 offen offset:384 nt
    s_waitcnt vmcnt(22)
    v_perm_b32 v107, v84, v80, s25
    v_perm_b32 v111, v84, v80, s26
    v_perm_b32 v115, v85, v81, s25
    v_perm_b32 v119, v85, v81, s26
    v_perm_b32 v123, v86, v82, s25
    v_perm_b32 v127, v86, v82, s26
    v_perm_b32 v131, v87, v83, s25
    v_perm_b32 v135, v87, v83, s26
    s_waitcnt vmcnt(6)
    buffer_load_dwordx4 v[80:83], v2, s[36:39], s53 offen offset:3072 nt
    s_waitcnt vmcnt(5)
    buffer_load_dwordx4 v[84:87], v2, s[36:39], s53 offen offset:3456 nt
    v_mfma_f32_16x16x32_bf16 v[152:155], v[104:107], v[12:15], v[152:155]
    v_mfma_f32_16x16x32_bf16 v[156:159], v[108:111], v[12:15], v[156:159]
    v_mfma_f32_16x16x32_bf16 v[160:163], v[112:115], v[12:15], v[160:163]
    v_mfma_f32_16x16x32_bf16 v[164:167], v[116:119], v[12:15], v[164:167]
    v_mfma_f32_16x16x32_bf16 v[168:171], v[120:123], v[12:15], v[168:171]
    v_mfma_f32_16x16x32_bf16 v[172:175], v[124:127], v[12:15], v[172:175]
    v_mfma_f32_16x16x32_bf16 v[176:179], v[128:131], v[12:15], v[176:179]
    v_mfma_f32_16x16x32_bf16 v[180:183], v[132:135], v[12:15], v[180:183]
    s_waitcnt vmcnt(22)
    v_perm_b32 v136, v92, v88, s25
    v_perm_b32 v138, v92, v88, s26
    v_perm_b32 v140, v93, v89, s25
    v_perm_b32 v142, v93, v89, s26
    v_perm_b32 v144, v94, v90, s25
    v_perm_b32 v146, v94, v90, s26
    v_perm_b32 v148, v95, v91, s25
    v_perm_b32 v150, v95, v91, s26
    s_waitcnt vmcnt(6)
    buffer_load_dwordx4 v[88:91], v3, s[36:39], s52 offen offset:256 nt
    s_waitcnt vmcnt(6)
    buffer_load_dwordx4 v[92:95], v3, s[36:39], s52 offen offset:3328 nt
    s_waitcnt vmcnt(22)
    v_perm_b32 v137, v100, v96, s25
    v_perm_b32 v139, v100, v96, s26
    v_perm_b32 v141, v101, v97, s25
    v_perm_b32 v143, v101, v97, s26
    v_perm_b32 v145, v102, v98, s25
    v_perm_b32 v147, v102, v98, s26
    v_perm_b32 v149, v103, v99, s25
    v_perm_b32 v151, v103, v99, s26
    s_waitcnt vmcnt(5)
    buffer_load_dwordx4 v[96:99], v3, s[36:39], s53 offen offset:256 nt
    s_waitcnt vmcnt(6)
    buffer_load_dwordx4 v[100:103], v3, s[36:39], s53 offen offset:3328 nt
    v_mfma_f32_16x16x16_bf16 v[184:187], v[136:137], v[16:17], v[184:187]
    v_mfma_f32_16x16x16_bf16 v[188:191], v[138:139], v[16:17], v[188:191]
    v_mfma_f32_16x16x16_bf16 v[192:195], v[140:141], v[16:17], v[192:195]
    v_mfma_f32_16x16x16_bf16 v[196:199], v[142:143], v[16:17], v[196:199]
    v_mfma_f32_16x16x16_bf16 v[200:203], v[144:145], v[16:17], v[200:203]
    v_mfma_f32_16x16x16_bf16 v[204:207], v[146:147], v[16:17], v[204:207]
    v_mfma_f32_16x16x16_bf16 v[208:211], v[148:149], v[16:17], v[208:211]
    v_mfma_f32_16x16x16_bf16 v[212:215], v[150:151], v[16:17], v[212:215]
    s_mov_b32 s48, s52
    s_mov_b32 s49, s53
    s_sub_u32 s22, s22, 1
    s_branch L_disp
L_totail:
    s_cmp_eq_u32 s3, 0
    s_cbranch_scc0 L_tail
    v_mov_b32 v9, 32
    s_mov_b64 exec, 1
    global_store_byte v226, v9, s[56:57]
    s_mov_b64 exec, -1
L_tail:
L_loop1:
    s_add_u32 s52, s48, 49152
    s_cmp_ge_u32 s52, 1572864
    s_cselect_b32 s27, 1572864, 0
    s_sub_u32 s52, s52, s27
    s_add_u32 s53, s52, 6144
    s_waitcnt vmcnt(21)
    v_mfma_f32_16x16x32_bf16 v[32:35], a[0:3], v[20:23], 0
    v_mfma_f32_16x16x32_bf16 v[32:35], a[4:7], v[24:27], v[32:35]
    v_mfma_f32_16x16x32_bf16 v[32:35], a[8:11], v[28:31], v[32:35]
    buffer_load_dwordx4 a[0:3], v1, s[32:35], s52 offen offset:0 nt
    buffer_load_dwordx4 a[4:7], v1, s[32:35], s52 offen offset:128 nt
    buffer_load_dwordx4 a[8:11], v1, s[32:35], s52 offen offset:256 nt
    s_waitcnt vmcnt(21)
    v_mfma_f32_16x16x32_bf16 v[36:39], a[12:15], v[20:23], 0
    v_mfma_f32_16x16x32_bf16 v[36:39], a[16:19], v[24:27], v[36:39]
    v_mfma_f32_16x16x32_bf16 v[36:39], a[20:23], v[28:31], v[36:39]
    buffer_load_dwordx4 a[12:15], v1, s[32:35], s52 offen offset:3072 nt
    buffer_load_dwordx4 a[16:19], v1, s[32:35], s52 offen offset:3200 nt
    buffer_load_dwordx4 a[20:23], v1, s[32:35], s52 offen offset:3328 nt
    s_waitcnt vmcnt(21)
    v_mfma_f32_16x16x32_bf16 v[40:43], a[24:27], v[20:23], 0
    v_mfma_f32_16x16x32_bf16 v[40:43], a[28:31], v[24:27], v[40:43]
    v_mfma_f32_16x16x32_bf16 v[40:43], a[32:35], v[28:31], v[40:43]
    buffer_load_dwordx4 a[24:27], v1, s[32:35], s53 offen offset:0 nt
    buffer_load_dwordx4 a[28:31], v1, s[32:35], s53 offen offset:128 nt
    buffer_load_dwordx4 a[32:35], v1, s[32:35], s53 offen offset:256 nt
    s_waitcnt vmcnt(21)
    v_mfma_f32_16x16x32_bf16 v[44:47], a[36:39], v[20:23], 0
    v_mfma_f32_16x16x32_bf16 v[44:47], a[40:43], v[24:27], v[44:47]
    v_mfma_f32_16x16x32_bf16 v[44:47], a[44:47], v[28:31], v[44:47]
    buffer_load_dwordx4 a[36:39], v1, s[32:35], s53 offen offset:3072 nt
    buffer_load_dwordx4 a[40:43], v1, s[32:35], s53 offen offset:3200 nt
    buffer_load_dwordx4 a[44:47], v1, s[32:35], s53 offen offset:3328 nt
    s_nop 4
    v_add_f32_dpp v32, v33, v32 row_half_mirror row_mask:0xf bank_mask:0xf
    v_add_f32_dpp v34, v35, v34 row_half_mirror row_mask:0xf bank_mask:0xf
    v_add_f32_dpp v36, v37, v36 row_half_mirror row_mask:0xf bank_mask:0xf
    v_add_f32_dpp v38, v39, v38 row_half_mirror row_mask:0xf bank_mask:0xf
    v_add_f32_dpp v40, v41, v40 row_half_mirror row_mask:0xf bank_mask:0xf
    v_add_f32_dpp v42, v43, v42 row_half_mirror row_mask:0xf bank_mask:0xf
    v_add_f32_dpp v44, v45, v44 row_half_mirror row_mask:0xf bank_mask:0xf
    v_add_f32_dpp v46, v47, v46 row_half_mirror row_mask:0xf bank_mask:0xf
    v_max3_f32 v8, v32, v34, v36
    v_max3_f32 v9, v38, v40, v42
    v_max3_f32 v8, v8, v44, v46
    v_max_f32 v8, v8, v9
    v_cmp_gt_f32 vcc, v8, v5
    s_cbranch_vccnz L_rescale1
L_back1:
    v_fma_f32 v48, v32, s24, -v6
    v_fma_f32 v49, v34, s24, -v6
    v_fma_f32 v50, v36, s24, -v6
    v_fma_f32 v51, v38, s24, -v6
    v_fma_f32 v52, v40, s24, -v6
    v_fma_f32 v53, v42, s24, -v6
    v_fma_f32 v54, v44, s24, -v6
    v_fma_f32 v55, v46, s24, -v6
    v_exp_f32 v48, v48
    v_exp_f32 v49, v49
    v_exp_f32 v50, v50
    v_exp_f32 v51, v51
    v_exp_f32 v52, v52
    v_exp_f32 v53, v53
    v_exp_f32 v54, v54
    v_exp_f32 v55, v55
    s_nop 0
    v_cvt_pk_bf16_f32 v12, v48, v49
    v_cvt_pk_bf16_f32 v13, v50, v51
    v_cvt_pk_bf16_f32 v14, v52, v53
    v_cvt_pk_bf16_f32 v15, v54, v55
    v_add_f32 v8, v48, v49
    v_add_f32 v9, v50, v51
    v_add_f32 v10, v52, v53
    v_add_f32 v11, v54, v55
    v_perm_b32 v16, v13, v12, v4
    v_perm_b32 v17, v15, v14, v4
    v_add_f32 v8, v8, v9
    v_add_f32 v10, v10, v11
    v_add_f32 v7, v7, v8
    v_add_f32 v7, v7, v10
    s_waitcnt vmcnt(22)
    v_perm_b32 v104, v60, v56, s25
    v_perm_b32 v108, v60, v56, s26
    v_perm_b32 v112, v61, v57, s25
    v_perm_b32 v116, v61, v57, s26
    v_perm_b32 v120, v62, v58, s25
    v_perm_b32 v124, v62, v58, s26
    v_perm_b32 v128, v63, v59, s25
    v_perm_b32 v132, v63, v59, s26
    buffer_load_dwordx4 v[56:59], v2, s[36:39], s52 offen offset:0 nt
    buffer_load_dwordx4 v[60:63], v2, s[36:39], s52 offen offset:384 nt
    s_waitcnt vmcnt(22)
    v_perm_b32 v105, v68, v64, s25
    v_perm_b32 v109, v68, v64, s26
    v_perm_b32 v113, v69, v65, s25
    v_perm_b32 v117, v69, v65, s26
    v_perm_b32 v121, v70, v66, s25
    v_perm_b32 v125, v70, v66, s26
    v_perm_b32 v129, v71, v67, s25
    v_perm_b32 v133, v71, v67, s26
    buffer_load_dwordx4 v[64:67], v2, s[36:39], s52 offen offset:3072 nt
    buffer_load_dwordx4 v[68:71], v2, s[36:39], s52 offen offset:3456 nt
    s_waitcnt vmcnt(22)
    v_perm_b32 v106, v76, v72, s25
    v_perm_b32 v110, v76, v72, s26
    v_perm_b32 v114, v77, v73, s25
    v_perm_b32 v118, v77, v73, s26
    v_perm_b32 v122, v78, v74, s25
    v_perm_b32 v126, v78, v74, s26
    v_perm_b32 v130, v79, v75, s25
    v_perm_b32 v134, v79, v75, s26
    buffer_load_dwordx4 v[72:75], v2, s[36:39], s53 offen offset:0 nt
    buffer_load_dwordx4 v[76:79], v2, s[36:39], s53 offen offset:384 nt
    s_waitcnt vmcnt(22)
    v_perm_b32 v107, v84, v80, s25
    v_perm_b32 v111, v84, v80, s26
    v_perm_b32 v115, v85, v81, s25
    v_perm_b32 v119, v85, v81, s26
    v_perm_b32 v123, v86, v82, s25
    v_perm_b32 v127, v86, v82, s26
    v_perm_b32 v131, v87, v83, s25
    v_perm_b32 v135, v87, v83, s26
    buffer_load_dwordx4 v[80:83], v2, s[36:39], s53 offen offset:3072 nt
    buffer_load_dwordx4 v[84:87], v2, s[36:39], s53 offen offset:3456 nt
    v_mfma_f32_16x16x32_bf16 v[152:155], v[104:107], v[12:15], v[152:155]
    v_mfma_f32_16x16x32_bf16 v[156:159], v[108:111], v[12:15], v[156:159]
    v_mfma_f32_16x16x32_bf16 v[160:163], v[112:115], v[12:15], v[160:163]
    v_mfma_f32_16x16x32_bf16 v[164:167], v[116:119], v[12:15], v[164:167]
    v_mfma_f32_16x16x32_bf16 v[168:171], v[120:123], v[12:15], v[168:171]
    v_mfma_f32_16x16x32_bf16 v[172:175], v[124:127], v[12:15], v[172:175]
    v_mfma_f32_16x16x32_bf16 v[176:179], v[128:131], v[12:15], v[176:179]
    v_mfma_f32_16x16x32_bf16 v[180:183], v[132:135], v[12:15], v[180:183]
    s_waitcnt vmcnt(22)
    v_perm_b32 v136, v92, v88, s25
    v_perm_b32 v138, v92, v88, s26
    v_perm_b32 v140, v93, v89, s25
    v_perm_b32 v142, v93, v89, s26
    v_perm_b32 v144, v94, v90, s25
    v_perm_b32 v146, v94, v90, s26
    v_perm_b32 v148, v95, v91, s25
    v_perm_b32 v150, v95, v91, s26
    buffer_load_dwordx4 v[88:91], v3, s[36:39], s52 offen offset:256 nt
    buffer_load_dwordx4 v[92:95], v3, s[36:39], s52 offen offset:3328 nt
    s_waitcnt vmcnt(22)
    v_perm_b32 v137, v100, v96, s25
    v_perm_b32 v139, v100, v96, s26
    v_perm_b32 v141, v101, v97, s25
    v_perm_b32 v143, v101, v97, s26
    v_perm_b32 v145, v102, v98, s25
    v_perm_b32 v147, v102, v98, s26
    v_perm_b32 v149, v103, v99, s25
    v_perm_b32 v151, v103, v99, s26
    buffer_load_dwordx4 v[96:99], v3, s[36:39], s53 offen offset:256 nt
    buffer_load_dwordx4 v[100:103], v3, s[36:39], s53 offen offset:3328 nt
    v_mfma_f32_16x16x16_bf16 v[184:187], v[136:137], v[16:17], v[184:187]
    v_mfma_f32_16x16x16_bf16 v[188:191], v[138:139], v[16:17], v[188:191]
    v_mfma_f32_16x16x16_bf16 v[192:195], v[140:141], v[16:17], v[192:195]
    v_mfma_f32_16x16x16_bf16 v[196:199], v[142:143], v[16:17], v[196:199]
    v_mfma_f32_16x16x16_bf16 v[200:203], v[144:145], v[16:17], v[200:203]
    v_mfma_f32_16x16x16_bf16 v[204:207], v[146:147], v[16:17], v[204:207]
    v_mfma_f32_16x16x16_bf16 v[208:211], v[148:149], v[16:17], v[208:211]
    v_mfma_f32_16x16x16_bf16 v[212:215], v[150:151], v[16:17], v[212:215]
    s_mov_b32 s48, s52
    s_mov_b32 s49, s53
    s_sub_u32 s22, s22, 1
    s_cmp_gt_u32 s22, 1
    s_cbranch_scc1 L_loop1
L_loop5:
    s_waitcnt vmcnt(21)
    v_mfma_f32_16x16x32_bf16 v[32:35], a[0:3], v[20:23], 0
    v_mfma_f32_16x16x32_bf16 v[32:35], a[4:7], v[24:27], v[32:35]
    v_mfma_f32_16x16x32_bf16 v[32:35], a[8:11], v[28:31], v[32:35]
    s_waitcnt vmcnt(18)
    v_mfma_f32_16x16x32_bf16 v[36:39], a[12:15], v[20:23], 0
    v_mfma_f32_16x16x32_bf16 v[36:39], a[16:19], v[24:27], v[36:39]
    v_mfma_f32_16x16x32_bf16 v[36:39], a[20:23], v[28:31], v[36:39]
    s_waitcnt vmcnt(15)
    v_mfma_f32_16x16x32_bf16 v[40:43], a[24:27], v[20:23], 0
    v_mfma_f32_16x16x32_bf16 v[40:43], a[28:31], v[24:27], v[40:43]
    v_mfma_f32_16x16x32_bf16 v[40:43], a[32:35], v[28:31], v[40:43]
    s_waitcnt vmcnt(12)
    v_mfma_f32_16x16x32_bf16 v[44:47], a[36:39], v[20:23], 0
    v_mfma_f32_16x16x32_bf16 v[44:47], a[40:43], v[24:27], v[44:47]
    v_mfma_f32_16x16x32_bf16 v[44:47], a[44:47], v[28:31], v[44:47]
    s_nop 7
    v_add_f32_dpp v32, v33, v32 row_half_mirror row_mask:0xf bank_mask:0xf
    v_add_f32_dpp v34, v35, v34 row_half_mirror row_mask:0xf bank_mask:0xf
    v_add_f32_dpp v36, v37, v36 row_half_mirror row_mask:0xf bank_mask:0xf
    v_add_f32_dpp v38, v39, v38 row_half_mirror row_mask:0xf bank_mask:0xf
    v_add_f32_dpp v40, v41, v40 row_half_mirror row_mask:0xf bank_mask:0xf
    v_add_f32_dpp v42, v43, v42 row_half_mirror row_mask:0xf bank_mask:0xf
    v_add_f32_dpp v44, v45, v44 row_half_mirror row_mask:0xf bank_mask:0xf
    v_add_f32_dpp v46, v47, v46 row_half_mirror row_mask:0xf bank_mask:0xf
    v_max3_f32 v8, v32, v34, v36
    v_max3_f32 v9, v38, v40, v42
    v_max3_f32 v8, v8, v44, v46
    v_max_f32 v8, v8, v9
    v_cmp_gt_f32 vcc, v8, v5
    s_cbranch_vccnz L_rescale5
L_back5:
    v_fma_f32 v48, v32, s24, -v6
    v_fma_f32 v49, v34, s24, -v6
    v_fma_f32 v50, v36, s24, -v6
    v_fma_f32 v51, v38, s24, -v6
    v_fma_f32 v52, v40, s24, -v6
    v_fma_f32 v53, v42, s24, -v6
    v_fma_f32 v54, v44, s24, -v6
    v_fma_f32 v55, v46, s24, -v6
    v_exp_f32 v48, v48
    v_exp_f32 v49, v49
    v_exp_f32 v50, v50
    v_exp_f32 v51, v51
    v_exp_f32 v52, v52
    v_exp_f32 v53, v53
    v_exp_f32 v54, v54
    v_exp_f32 v55, v55
    s_nop 0
    v_cvt_pk_bf16_f32 v12, v48, v49
    v_cvt_pk_bf16_f32 v13, v50, v51
    v_cvt_pk_bf16_f32 v14, v52, v53
    v_cvt_pk_bf16_f32 v15, v54, v55
    v_add_f32 v8, v48, v49
    v_add_f32 v9, v50, v51
    v_add_f32 v10, v52, v53
    v_add_f32 v11, v54, v55
    v_perm_b32 v16, v13, v12, v4
    v_perm_b32 v17, v15, v14, v4
    v_add_f32 v8, v8, v9
    v_add_f32 v10, v10, v11
    v_add_f32 v7, v7, v8
    v_add_f32 v7, v7, v10
    s_waitcnt vmcnt(10)
    v_perm_b32 v104, v60, v56, s25
    v_perm_b32 v108, v60, v56, s26
    v_perm_b32 v112, v61, v57, s25
    v_perm_b32 v116, v61, v57, s26
    v_perm_b32 v120, v62, v58, s25
    v_perm_b32 v124, v62, v58, s26
    v_perm_b32 v128, v63, v59, s25
    v_perm_b32 v132, v63, v59, s26
    s_waitcnt vmcnt(8)
    v_perm_b32 v105, v68, v64, s25
    v_perm_b32 v109, v68, v64, s26
    v_perm_b32 v113, v69, v65, s25
    v_perm_b32 v117, v69, v65, s26
    v_perm_b32 v121, v70, v66, s25
    v_perm_b32 v125, v70, v66, s26
    v_perm_b32 v129, v71, v67, s25
    v_perm_b32 v133, v71, v67, s26
    s_waitcnt vmcnt(6)
    v_perm_b32 v106, v76, v72, s25
    v_perm_b32 v110, v76, v72, s26
    v_perm_b32 v114, v77, v73, s25
    v_perm_b32 v118, v77, v73, s26
    v_perm_b32 v122, v78, v74, s25
    v_perm_b32 v126, v78, v74, s26
    v_perm_b32 v130, v79, v75, s25
    v_perm_b32 v134, v79, v75, s26
    s_waitcnt vmcnt(4)
    v_perm_b32 v107, v84, v80, s25
    v_perm_b32 v111, v84, v80, s26
    v_perm_b32 v115, v85, v81, s25
    v_perm_b32 v119, v85, v81, s26
    v_perm_b32 v123, v86, v82, s25
    v_perm_b32 v127, v86, v82, s26
    v_perm_b32 v131, v87, v83, s25
    v_perm_b32 v135, v87, v83, s26
    v_mfma_f32_16x16x32_bf16 v[152:155], v[104:107], v[12:15], v[152:155]
    v_mfma_f32_16x16x32_bf16 v[156:159], v[108:111], v[12:15], v[156:159]
    v_mfma_f32_16x16x32_bf16 v[160:163], v[112:115], v[12:15], v[160:163]
    v_mfma_f32_16x16x32_bf16 v[164:167], v[116:119], v[12:15], v[164:167]
    v_mfma_f32_16x16x32_bf16 v[168:171], v[120:123], v[12:15], v[168:171]
    v_mfma_f32_16x16x32_bf16 v[172:175], v[124:127], v[12:15], v[172:175]
    v_mfma_f32_16x16x32_bf16 v[176:179], v[128:131], v[12:15], v[176:179]
    v_mfma_f32_16x16x32_bf16 v[180:183], v[132:135], v[12:15], v[180:183]
    s_waitcnt vmcnt(2)
    v_perm_b32 v136, v92, v88, s25
    v_perm_b32 v138, v92, v88, s26
    v_perm_b32 v140, v93, v89, s25
    v_perm_b32 v142, v93, v89, s26
    v_perm_b32 v144, v94, v90, s25
    v_perm_b32 v146, v94, v90, s26
    v_perm_b32 v148, v95, v91, s25
    v_perm_b32 v150, v95, v91, s26
    s_waitcnt vmcnt(0)
    v_perm_b32 v137, v100, v96, s25
    v_perm_b32 v139, v100, v96, s26
    v_perm_b32 v141, v101, v97, s25
    v_perm_b32 v143, v101, v97, s26
    v_perm_b32 v145, v102, v98, s25
    v_perm_b32 v147, v102, v98, s26
    v_perm_b32 v149, v103, v99, s25
    v_perm_b32 v151, v103, v99, s26
    v_mfma_f32_16x16x16_bf16 v[184:187], v[136:137], v[16:17], v[184:187]
    v_mfma_f32_16x16x16_bf16 v[188:191], v[138:139], v[16:17], v[188:191]
    v_mfma_f32_16x16x16_bf16 v[192:195], v[140:141], v[16:17], v[192:195]
    v_mfma_f32_16x16x16_bf16 v[196:199], v[142:143], v[16:17], v[196:199]
    v_mfma_f32_16x16x16_bf16 v[200:203], v[144:145], v[16:17], v[200:203]
    v_mfma_f32_16x16x16_bf16 v[204:207], v[146:147], v[16:17], v[204:207]
    v_mfma_f32_16x16x16_bf16 v[208:211], v[148:149], v[16:17], v[208:211]
    v_mfma_f32_16x16x16_bf16 v[212:215], v[150:151], v[16:17], v[212:215]
    s_mov_b32 s48, s52
    s_mov_b32 s49, s53
    s_sub_u32 s22, s22, 1
L_epi:
    v_mov_b32 v8, v7
    s_mov_b32 exec_lo, 0x000f000f
    s_mov_b32 exec_hi, 0x000f000f
    ds_write_b128 v216, v[152:155] offset:0
    ds_write_b128 v216, v[156:159] offset:16
    ds_write_b128 v216, v[160:163] offset:32
    ds_write_b128 v216, v[164:167] offset:48
    ds_write_b128 v216, v[168:171] offset:64
    ds_write_b128 v216, v[172:175] offset:80
    ds_write_b128 v216, v[176:179] offset:96
    ds_write_b128 v216, v[180:183] offset:112
    s_mov_b64 exec, -1
    v_permlane16_swap_b32 v8, v7
    s_nop 1
    v_add_f32 v7, v7, v8
    v_mov_b32 v8, v7
    s_mov_b32 exec_lo, 0x000f000f
    s_mov_b32 exec_hi, 0x0f000f00
    ds_write_b128 v216, v[184:187] offset:512
    ds_write_b128 v216, v[188:191] offset:528
    ds_write_b128 v216, v[192:195] offset:544
    ds_write_b128 v216, v[196:199] offset:560
    ds_write_b128 v216, v[200:203] offset:576
    ds_write_b128 v216, v[204:207] offset:592
    ds_write_b128 v216, v[208:211] offset:608
    ds_write_b128 v216, v[212:215] offset:624
    s_mov_b64 exec, -1
    v_permlane32_swap_b32 v8, v7
    s_nop 1
    v_add_f32 v9, v7, v8
    v_mov_b32 v8, v5
    s_mov_b64 exec, 15
    ds_write_b64 v217, v[8:9] offset:4160
    s_mov_b64 exec, -1
    s_waitcnt lgkmcnt(0)
    s_barrier
    s_cmp_ge_u32 s3, 3
    s_cbranch_scc1 L_fin
    ds_read_b64 v[120:121], v219 offset:4160
    ds_read_b64 v[122:123], v219 offset:8384
    ds_read_b64 v[124:125], v219 offset:12608
    ds_read_b64 v[126:127], v219 offset:16832
    ds_read_b128 v[32:35], v218 offset:0
    ds_read_b128 v[36:39], v218 offset:4224
    ds_read_b128 v[40:43], v218 offset:8448
    ds_read_b128 v[44:47], v218 offset:12672
    s_cmp_eq_u32 s3, 2
    s_cbranch_scc0 L_noy
    ds_read_b128 v[104:107], v218 offset:256
    ds_read_b128 v[108:111], v218 offset:4480
    ds_read_b128 v[112:115], v218 offset:8704
    ds_read_b128 v[116:119], v218 offset:12928
    s_waitcnt lgkmcnt(0)
    v_add_f32 v32, v32, v104
    v_add_f32 v33, v33, v105
    v_add_f32 v34, v34, v106
    v_add_f32 v35, v35, v107
    v_add_f32 v36, v36, v108
    v_add_f32 v37, v37, v109
    v_add_f32 v38, v38, v110
    v_add_f32 v39, v39, v111
    v_add_f32 v40, v40, v112
    v_add_f32 v41, v41, v113
    v_add_f32 v42, v42, v114
    v_add_f32 v43, v43, v115
    v_add_f32 v44, v44, v116
    v_add_f32 v45, v45, v117
    v_add_f32 v46, v46, v118
    v_add_f32 v47, v47, v119
L_noy:
    s_waitcnt lgkmcnt(4)
    v_max3_f32 v8, v120, v122, v124
    v_max_f32 v8, v8, v126
    v_sub_f32 v120, v120, v8
    v_sub_f32 v122, v122, v8
    v_sub_f32 v124, v124, v8
    v_sub_f32 v126, v126, v8
    v_mul_f32 v120, s24, v120
    v_mul_f32 v122, s24, v122
    v_mul_f32 v124, s24, v124
    v_mul_f32 v126, s24, v126
    v_exp_f32 v120, v120
    v_exp_f32 v122, v122
    v_exp_f32 v124, v124
    v_exp_f32 v126, v126
    s_nop 0
    v_mul_f32 v9, v120, v121
    v_fmac_f32 v9, v122, v123
    v_fmac_f32 v9, v124, v125
    v_fmac_f32 v9, v126, v127
    v_rcp_f32 v9, v9
    s_waitcnt lgkmcnt(0)
    v_mul_f32 v104, v120, v32
    v_mul_f32 v105, v120, v33
    v_mul_f32 v106, v120, v34
    v_mul_f32 v107, v120, v35
    v_fmac_f32 v104, v122, v36
    v_fmac_f32 v105, v122, v37
    v_fmac_f32 v106, v122, v38
    v_fmac_f32 v107, v122, v39
    v_fmac_f32 v104, v124, v40
    v_fmac_f32 v105, v124, v41
    v_fmac_f32 v106, v124, v42
    v_fmac_f32 v107, v124, v43
    v_fmac_f32 v104, v126, v44
    v_fmac_f32 v105, v126, v45
    v_fmac_f32 v106, v126, v46
    v_fmac_f32 v107, v126, v47
    v_mul_f32 v104, v104, v9
    v_mul_f32 v105, v105, v9
    v_mul_f32 v106, v106, v9
    v_mul_f32 v107, v107, v9
    v_cvt_pk_bf16_f32 v108, v104, v105
    v_cvt_pk_bf16_f32 v109, v106, v107
    global_store_short v220, v108, s[10:11]
    global_store_short_d16_hi v220, v108, s[10:11] offset:16
    global_store_short v220, v109, s[10:11] offset:32
    global_store_short_d16_hi v220, v109, s[10:11] offset:48
L_fin:
L_done:
    s_endpgm
L_rescale0:
    v_max_f32 v8, v8, v5
    v_mov_b32 v9, v8
    s_nop 1
    v_permlane16_swap_b32 v9, v8
    s_nop 1
    v_max_f32 v8, v8, v9
    v_mov_b32 v9, v8
    s_nop 1
    v_permlane32_swap_b32 v9, v8
    s_nop 1
    v_max_f32 v8, v8, v9
    v_sub_f32 v9, v5, v8
    v_mul_f32 v9, s24, v9
    v_exp_f32 v9, v9
    v_mov_b32 v5, v8
    v_mul_f32 v6, s24, v8
    v_mul_f32 v7, v7, v9
    v_mul_f32 v152, v9, v152
    v_mul_f32 v153, v9, v153
    v_mul_f32 v154, v9, v154
    v_mul_f32 v155, v9, v155
    v_mul_f32 v156, v9, v156
    v_mul_f32 v157, v9, v157
    v_mul_f32 v158, v9, v158
    v_mul_f32 v159, v9, v159
    v_mul_f32 v160, v9, v160
    v_mul_f32 v161, v9, v161
    v_mul_f32 v162, v9, v162
    v_mul_f32 v163, v9, v163
    v_mul_f32 v164, v9, v164
    v_mul_f32 v165, v9, v165
    v_mul_f32 v166, v9, v166
    v_mul_f32 v167, v9, v167
    v_mul_f32 v168, v9, v168
    v_mul_f32 v169, v9, v169
    v_mul_f32 v170, v9, v170
    v_mul_f32 v171, v9, v171
    v_mul_f32 v172, v9, v172
    v_mul_f32 v173, v9, v173
    v_mul_f32 v174, v9, v174
    v_mul_f32 v175, v9, v175
    v_mul_f32 v176, v9, v176
    v_mul_f32 v177, v9, v177
    v_mul_f32 v178, v9, v178
    v_mul_f32 v179, v9, v179
    v_mul_f32 v180, v9, v180
    v_mul_f32 v181, v9, v181
    v_mul_f32 v182, v9, v182
    v_mul_f32 v183, v9, v183
    v_mul_f32 v184, v9, v184
    v_mul_f32 v185, v9, v185
    v_mul_f32 v186, v9, v186
    v_mul_f32 v187, v9, v187
    v_mul_f32 v188, v9, v188
    v_mul_f32 v189, v9, v189
    v_mul_f32 v190, v9, v190
    v_mul_f32 v191, v9, v191
    v_mul_f32 v192, v9, v192
    v_mul_f32 v193, v9, v193
    v_mul_f32 v194, v9, v194
    v_mul_f32 v195, v9, v195
    v_mul_f32 v196, v9, v196
    v_mul_f32 v197, v9, v197
    v_mul_f32 v198, v9, v198
    v_mul_f32 v199, v9, v199
    v_mul_f32 v200, v9, v200
    v_mul_f32 v201, v9, v201
    v_mul_f32 v202, v9, v202
    v_mul_f32 v203, v9, v203
    v_mul_f32 v204, v9, v204
    v_mul_f32 v205, v9, v205
    v_mul_f32 v206, v9, v206
    v_mul_f32 v207, v9, v207
    v_mul_f32 v208, v9, v208
    v_mul_f32 v209, v9, v209
    v_mul_f32 v210, v9, v210
    v_mul_f32 v211, v9, v211
    v_mul_f32 v212, v9, v212
    v_mul_f32 v213, v9, v213
    v_mul_f32 v214, v9, v214
    v_mul_f32 v215, v9, v215
    s_branch L_back0
L_rescale1:
    v_max_f32 v8, v8, v5
    v_mov_b32 v9, v8
    s_nop 1
    v_permlane16_swap_b32 v9, v8
    s_nop 1
    v_max_f32 v8, v8, v9
    v_mov_b32 v9, v8
    s_nop 1
    v_permlane32_swap_b32 v9, v8
    s_nop 1
    v_max_f32 v8, v8, v9
    v_sub_f32 v9, v5, v8
    v_mul_f32 v9, s24, v9
    v_exp_f32 v9, v9
    v_mov_b32 v5, v8
    v_mul_f32 v6, s24, v8
    v_mul_f32 v7, v7, v9
    v_mul_f32 v152, v9, v152
    v_mul_f32 v153, v9, v153
    v_mul_f32 v154, v9, v154
    v_mul_f32 v155, v9, v155
    v_mul_f32 v156, v9, v156
    v_mul_f32 v157, v9, v157
    v_mul_f32 v158, v9, v158
    v_mul_f32 v159, v9, v159
    v_mul_f32 v160, v9, v160
    v_mul_f32 v161, v9, v161
    v_mul_f32 v162, v9, v162
    v_mul_f32 v163, v9, v163
    v_mul_f32 v164, v9, v164
    v_mul_f32 v165, v9, v165
    v_mul_f32 v166, v9, v166
    v_mul_f32 v167, v9, v167
    v_mul_f32 v168, v9, v168
    v_mul_f32 v169, v9, v169
    v_mul_f32 v170, v9, v170
    v_mul_f32 v171, v9, v171
    v_mul_f32 v172, v9, v172
    v_mul_f32 v173, v9, v173
    v_mul_f32 v174, v9, v174
    v_mul_f32 v175, v9, v175
    v_mul_f32 v176, v9, v176
    v_mul_f32 v177, v9, v177
    v_mul_f32 v178, v9, v178
    v_mul_f32 v179, v9, v179
    v_mul_f32 v180, v9, v180
    v_mul_f32 v181, v9, v181
    v_mul_f32 v182, v9, v182
    v_mul_f32 v183, v9, v183
    v_mul_f32 v184, v9, v184
    v_mul_f32 v185, v9, v185
    v_mul_f32 v186, v9, v186
    v_mul_f32 v187, v9, v187
    v_mul_f32 v188, v9, v188
    v_mul_f32 v189, v9, v189
    v_mul_f32 v190, v9, v190
    v_mul_f32 v191, v9, v191
    v_mul_f32 v192, v9, v192
    v_mul_f32 v193, v9, v193
    v_mul_f32 v194, v9, v194
    v_mul_f32 v195, v9, v195
    v_mul_f32 v196, v9, v196
    v_mul_f32 v197, v9, v197
    v_mul_f32 v198, v9, v198
    v_mul_f32 v199, v9, v199
    v_mul_f32 v200, v9, v200
    v_mul_f32 v201, v9, v201
    v_mul_f32 v202, v9, v202
    v_mul_f32 v203, v9, v203
    v_mul_f32 v204, v9, v204
    v_mul_f32 v205, v9, v205
    v_mul_f32 v206, v9, v206
    v_mul_f32 v207, v9, v207
    v_mul_f32 v208, v9, v208
    v_mul_f32 v209, v9, v209
    v_mul_f32 v210, v9, v210
    v_mul_f32 v211, v9, v211
    v_mul_f32 v212, v9, v212
    v_mul_f32 v213, v9, v213
    v_mul_f32 v214, v9, v214
    v_mul_f32 v215, v9, v215
    s_branch L_back1
L_rescale5:
    v_max_f32 v8, v8, v5
    v_mov_b32 v9, v8
    s_nop 1
    v_permlane16_swap_b32 v9, v8
    s_nop 1
    v_max_f32 v8, v8, v9
    v_mov_b32 v9, v8
    s_nop 1
    v_permlane32_swap_b32 v9, v8
    s_nop 1
    v_max_f32 v8, v8, v9
    v_sub_f32 v9, v5, v8
    v_mul_f32 v9, s24, v9
    v_exp_f32 v9, v9
    v_mov_b32 v5, v8
    v_mul_f32 v6, s24, v8
    v_mul_f32 v7, v7, v9
    v_mul_f32 v152, v9, v152
    v_mul_f32 v153, v9, v153
    v_mul_f32 v154, v9, v154
    v_mul_f32 v155, v9, v155
    v_mul_f32 v156, v9, v156
    v_mul_f32 v157, v9, v157
    v_mul_f32 v158, v9, v158
    v_mul_f32 v159, v9, v159
    v_mul_f32 v160, v9, v160
    v_mul_f32 v161, v9, v161
    v_mul_f32 v162, v9, v162
    v_mul_f32 v163, v9, v163
    v_mul_f32 v164, v9, v164
    v_mul_f32 v165, v9, v165
    v_mul_f32 v166, v9, v166
    v_mul_f32 v167, v9, v167
    v_mul_f32 v168, v9, v168
    v_mul_f32 v169, v9, v169
    v_mul_f32 v170, v9, v170
    v_mul_f32 v171, v9, v171
    v_mul_f32 v172, v9, v172
    v_mul_f32 v173, v9, v173
    v_mul_f32 v174, v9, v174
    v_mul_f32 v175, v9, v175
    v_mul_f32 v176, v9, v176
    v_mul_f32 v177, v9, v177
    v_mul_f32 v178, v9, v178
    v_mul_f32 v179, v9, v179
    v_mul_f32 v180, v9, v180
    v_mul_f32 v181, v9, v181
    v_mul_f32 v182, v9, v182
    v_mul_f32 v183, v9, v183
    v_mul_f32 v184, v9, v184
    v_mul_f32 v185, v9, v185
    v_mul_f32 v186, v9, v186
    v_mul_f32 v187, v9, v187
    v_mul_f32 v188, v9, v188
    v_mul_f32 v189, v9, v189
    v_mul_f32 v190, v9, v190
    v_mul_f32 v191, v9, v191
    v_mul_f32 v192, v9, v192
    v_mul_f32 v193, v9, v193
    v_mul_f32 v194, v9, v194
    v_mul_f32 v195, v9, v195
    v_mul_f32 v196, v9, v196
    v_mul_f32 v197, v9, v197
    v_mul_f32 v198, v9, v198
    v_mul_f32 v199, v9, v199
    v_mul_f32 v200, v9, v200
    v_mul_f32 v201, v9, v201
    v_mul_f32 v202, v9, v202
    v_mul_f32 v203, v9, v203
    v_mul_f32 v204, v9, v204
    v_mul_f32 v205, v9, v205
    v_mul_f32 v206, v9, v206
    v_mul_f32 v207, v9, v207
    v_mul_f32 v208, v9, v208
    v_mul_f32 v209, v9, v209
    v_mul_f32 v210, v9, v210
    v_mul_f32 v211, v9, v211
    v_mul_f32 v212, v9, v212
    v_mul_f32 v213, v9, v213
    v_mul_f32 v214, v9, v214
    v_mul_f32 v215, v9, v215
    s_branch L_back5
L_rescale3:
    v_max_f32 v8, v8, v5
    v_mov_b32 v9, v8
    s_nop 1
    v_permlane16_swap_b32 v9, v8
    s_nop 1
    v_max_f32 v8, v8, v9
    v_mov_b32 v9, v8
    s_nop 1
    v_permlane32_swap_b32 v9, v8
    s_nop 1
    v_max_f32 v8, v8, v9
    v_sub_f32 v9, v5, v8
    v_mul_f32 v9, s24, v9
    v_exp_f32 v9, v9
    v_mov_b32 v5, v8
    v_mul_f32 v6, s24, v8
    v_mul_f32 v7, v7, v9
    v_mul_f32 v152, v9, v152
    v_mul_f32 v153, v9, v153
    v_mul_f32 v154, v9, v154
    v_mul_f32 v155, v9, v155
    v_mul_f32 v156, v9, v156
    v_mul_f32 v157, v9, v157
    v_mul_f32 v158, v9, v158
    v_mul_f32 v159, v9, v159
    v_mul_f32 v160, v9, v160
    v_mul_f32 v161, v9, v161
    v_mul_f32 v162, v9, v162
    v_mul_f32 v163, v9, v163
    v_mul_f32 v164, v9, v164
    v_mul_f32 v165, v9, v165
    v_mul_f32 v166, v9, v166
    v_mul_f32 v167, v9, v167
    v_mul_f32 v168, v9, v168
    v_mul_f32 v169, v9, v169
    v_mul_f32 v170, v9, v170
    v_mul_f32 v171, v9, v171
    v_mul_f32 v172, v9, v172
    v_mul_f32 v173, v9, v173
    v_mul_f32 v174, v9, v174
    v_mul_f32 v175, v9, v175
    v_mul_f32 v176, v9, v176
    v_mul_f32 v177, v9, v177
    v_mul_f32 v178, v9, v178
    v_mul_f32 v179, v9, v179
    v_mul_f32 v180, v9, v180
    v_mul_f32 v181, v9, v181
    v_mul_f32 v182, v9, v182
    v_mul_f32 v183, v9, v183
    v_mul_f32 v184, v9, v184
    v_mul_f32 v185, v9, v185
    v_mul_f32 v186, v9, v186
    v_mul_f32 v187, v9, v187
    v_mul_f32 v188, v9, v188
    v_mul_f32 v189, v9, v189
    v_mul_f32 v190, v9, v190
    v_mul_f32 v191, v9, v191
    v_mul_f32 v192, v9, v192
    v_mul_f32 v193, v9, v193
    v_mul_f32 v194, v9, v194
    v_mul_f32 v195, v9, v195
    v_mul_f32 v196, v9, v196
    v_mul_f32 v197, v9, v197
    v_mul_f32 v198, v9, v198
    v_mul_f32 v199, v9, v199
    v_mul_f32 v200, v9, v200
    v_mul_f32 v201, v9, v201
    v_mul_f32 v202, v9, v202
    v_mul_f32 v203, v9, v203
    v_mul_f32 v204, v9, v204
    v_mul_f32 v205, v9, v205
    v_mul_f32 v206, v9, v206
    v_mul_f32 v207, v9, v207
    v_mul_f32 v208, v9, v208
    v_mul_f32 v209, v9, v209
    v_mul_f32 v210, v9, v210
    v_mul_f32 v211, v9, v211
    v_mul_f32 v212, v9, v212
    v_mul_f32 v213, v9, v213
    v_mul_f32 v214, v9, v214
    v_mul_f32 v215, v9, v215
    s_branch L_back3
L_rescale4:
    v_max_f32 v8, v8, v5
    v_mov_b32 v9, v8
    s_nop 1
    v_permlane16_swap_b32 v9, v8
    s_nop 1
    v_max_f32 v8, v8, v9
    v_mov_b32 v9, v8
    s_nop 1
    v_permlane32_swap_b32 v9, v8
    s_nop 1
    v_max_f32 v8, v8, v9
    v_sub_f32 v9, v5, v8
    v_mul_f32 v9, s24, v9
    v_exp_f32 v9, v9
    v_mov_b32 v5, v8
    v_mul_f32 v6, s24, v8
    v_mul_f32 v7, v7, v9
    v_mul_f32 v152, v9, v152
    v_mul_f32 v153, v9, v153
    v_mul_f32 v154, v9, v154
    v_mul_f32 v155, v9, v155
    v_mul_f32 v156, v9, v156
    v_mul_f32 v157, v9, v157
    v_mul_f32 v158, v9, v158
    v_mul_f32 v159, v9, v159
    v_mul_f32 v160, v9, v160
    v_mul_f32 v161, v9, v161
    v_mul_f32 v162, v9, v162
    v_mul_f32 v163, v9, v163
    v_mul_f32 v164, v9, v164
    v_mul_f32 v165, v9, v165
    v_mul_f32 v166, v9, v166
    v_mul_f32 v167, v9, v167
    v_mul_f32 v168, v9, v168
    v_mul_f32 v169, v9, v169
    v_mul_f32 v170, v9, v170
    v_mul_f32 v171, v9, v171
    v_mul_f32 v172, v9, v172
    v_mul_f32 v173, v9, v173
    v_mul_f32 v174, v9, v174
    v_mul_f32 v175, v9, v175
    v_mul_f32 v176, v9, v176
    v_mul_f32 v177, v9, v177
    v_mul_f32 v178, v9, v178
    v_mul_f32 v179, v9, v179
    v_mul_f32 v180, v9, v180
    v_mul_f32 v181, v9, v181
    v_mul_f32 v182, v9, v182
    v_mul_f32 v183, v9, v183
    v_mul_f32 v184, v9, v184
    v_mul_f32 v185, v9, v185
    v_mul_f32 v186, v9, v186
    v_mul_f32 v187, v9, v187
    v_mul_f32 v188, v9, v188
    v_mul_f32 v189, v9, v189
    v_mul_f32 v190, v9, v190
    v_mul_f32 v191, v9, v191
    v_mul_f32 v192, v9, v192
    v_mul_f32 v193, v9, v193
    v_mul_f32 v194, v9, v194
    v_mul_f32 v195, v9, v195
    v_mul_f32 v196, v9, v196
    v_mul_f32 v197, v9, v197
    v_mul_f32 v198, v9, v198
    v_mul_f32 v199, v9, v199
    v_mul_f32 v200, v9, v200
    v_mul_f32 v201, v9, v201
    v_mul_f32 v202, v9, v202
    v_mul_f32 v203, v9, v203
    v_mul_f32 v204, v9, v204
    v_mul_f32 v205, v9, v205
    v_mul_f32 v206, v9, v206
    v_mul_f32 v207, v9, v207
    v_mul_f32 v208, v9, v208
    v_mul_f32 v209, v9, v209
    v_mul_f32 v210, v9, v210
    v_mul_f32 v211, v9, v211
    v_mul_f32 v212, v9, v212
    v_mul_f32 v213, v9, v213
    v_mul_f32 v214, v9, v214
    v_mul_f32 v215, v9, v215
    s_branch L_back4
L_codeend:
.section .rodata,"a"
.p2align 6
.amdhsa_kernel standalone__mha_softmax__sampling_kernel
  .amdhsa_next_free_vgpr 276
  .amdhsa_next_free_sgpr 96
  .amdhsa_accum_offset 228
  .amdhsa_group_segment_fixed_size 0
  .amdhsa_kernarg_size 48
  .amdhsa_user_sgpr_count 2
  .amdhsa_user_sgpr_kernarg_segment_ptr 1
  .amdhsa_system_sgpr_workgroup_id_x 1
  .amdhsa_float_denorm_mode_32 3
.end_amdhsa_kernel
```
